```python
import torch

def _softmax(x, axis=-1):
    return torch.softmax(x, dim=axis)
def _gelu(x):
    return torch.nn.functional.gelu(x, approximate="tanh")
def _silu(x):
    return torch.nn.functional.silu(x)
def _sigmoid(x):
    return torch.sigmoid(x)
def _layernorm(x, axis=-1, eps=1e-5):
    m = x.mean(dim=axis, keepdim=True)
    v = x.var(dim=axis, keepdim=True, unbiased=False)
    return (x - m) / torch.sqrt(v + eps)
def _scatter_add(tgt, idx, src, axis=0):
    return tgt.clone().index_add_(axis, idx, src)
def _segment_sum(src, seg, n):
    out = torch.zeros((n,) + src.shape[1:], dtype=src.dtype)
    return out.index_add_(0, seg, src)
def _pad(x, pw):
    flat = tuple(v for pair in reversed(pw) for v in pair)
    return torch.nn.functional.pad(x, flat)

kernel_name = 'standalone__moe_arch_mod__prompt'

def setup_inputs():

    _w = (lambda a: (lambda t: t.to(torch.bfloat16) if t.is_floating_point() else t)(torch.as_tensor(a)))
    B, S, D, F, C = 1, 2048, 576, 4608, 2
    return {
        "x": _w((lambda *s: torch.randn(*s, dtype=torch.bfloat16) * 0.1)(B, S, D)),
        "w_r": _w((lambda *s: torch.randn(*s, dtype=torch.bfloat16) * 0.1)(D)),
        "w_gate": _w((lambda *s: torch.randn(*s, dtype=torch.bfloat16) * 0.1)(D, F)),
        "w_up": _w((lambda *s: torch.randn(*s, dtype=torch.bfloat16) * 0.1)(D, F)),
        "w_down": _w((lambda *s: torch.randn(*s, dtype=torch.bfloat16) * 0.1)(F, D)),
    }

def reference(x, w_r, w_gate, w_up, w_down):
    B, S, D = x.shape
    C = 2
    r = x @ w_r
    idx = torch.argsort(-r, axis=-1)[:, :C]
    idx_e = (lambda x, n, axis: torch.repeat_interleave(x, n, dim=axis))(idx.reshape(B, C, 1), D, axis=2)
    x_sel = (lambda x, i, axis: torch.take_along_dim(x, i, dim=axis))(x, idx_e, axis=1)
    g = _silu(x_sel @ w_gate)
    u = x_sel @ w_up
    y = (g * u) @ w_down
    r_sel = _sigmoid((lambda x, i, axis: torch.take_along_dim(x, i, dim=axis))(r, idx, axis=1))
    y = y * r_sel.reshape(B, C, 1)
    b_off = (torch.arange(B) * S).reshape(B, 1)
    flat_idx = (idx + b_off).reshape(B * C)
    zero = (x * 0.0).reshape(B * S, D)
    upd = _scatter_add(zero, flat_idx, y.reshape(B * C, D), axis=0)
    return x + upd.reshape(B, S, D)
```

```asm
; @launch grid=(256,1,1) block=(576,1,1) lds=75776
.amdgcn_target "amdgcn-amd-amdhsa--gfx950"
.text
.globl standalone__moe_arch_mod__prompt_kernel
.p2align 8
.type standalone__moe_arch_mod__prompt_kernel,@function
standalone__moe_arch_mod__prompt_kernel:
    s_load_dwordx16 s[4:19], s[0:1], 0
    v_lshrrev_b32 v1, 6, v0
    s_cmp_ge_u32 s2, 256
    s_cbranch_scc1 L_end
    v_readfirstlane_b32 s3, v1
    v_and_b32 v0, 63, v0
    s_cmp_lg_u32 s3, 0
    s_cbranch_scc1 L_other
    v_lshrrev_b32 v1, 3, v0
    v_and_b32 v2, 7, v0
    v_lshlrev_b32 v2, 4, v2
    s_lshl_b32 s24, s2, 3
    v_add_u32 v3, s24, v1
    v_mul_u32_u24 v4, 1152, v3
    v_add_u32 v4, v4, v2
    v_mov_b32 v7, 0
    v_lshlrev_b32 v5, 4, v0
    s_mov_b32 m0, 64
    s_waitcnt lgkmcnt(0)
    global_load_lds_dwordx4 v5, s[6:7]
    s_mov_b64 exec, 0xff
    global_load_lds_dwordx4 v5, s[6:7] offset:1024
    global_load_dword v6, v7, s[18:19] sc1
    s_mov_b64 exec, -1
    global_load_dwordx4 v[8:11], v4, s[4:5] offset:0 nt
    global_load_dwordx4 v[12:15], v4, s[4:5] offset:128 nt
    global_load_dwordx4 v[16:19], v4, s[4:5] offset:256 nt
    global_load_dwordx4 v[20:23], v4, s[4:5] offset:384 nt
    global_load_dwordx4 v[24:27], v4, s[4:5] offset:512 nt
    global_load_dwordx4 v[28:31], v4, s[4:5] offset:640 nt
    global_load_dwordx4 v[32:35], v4, s[4:5] offset:768 nt
    global_load_dwordx4 v[36:39], v4, s[4:5] offset:896 nt
    global_load_dwordx4 v[40:43], v4, s[4:5] offset:1024 nt
    s_branch L_r2
L_other:
    s_cmp_lt_u32 s2, 216
    s_cbranch_scc1 L_cw
    s_cmp_lg_u32 s3, 6
    s_cbranch_scc1 L_red
    s_getpc_b64 s[60:61]
L_pc:
    s_add_u32 s60, s60, L_pce-L_pc
    s_addc_u32 s61, s61, 0
    s_cmp_lt_u32 s2, 224
    s_cbranch_scc1 L_padA
    s_cmp_lt_u32 s2, 232
    s_cbranch_scc1 L_padB
    s_cmp_lt_u32 s2, 240
    s_cbranch_scc1 L_padD
L_pce:
    s_endpgm
L_cw:
    s_lshr_b32 s20, s2, 3
    s_mul_i32 s21, s20, 43
    s_lshr_b32 s21, s21, 7
    s_mul_i32 s22, s21, 3
    s_sub_u32 s22, s20, s22
    s_and_b32 s23, s2, 7
    s_mul_i32 s32, s20, 57
    s_lshr_b32 s32, s32, 9
    s_mul_i32 s33, s32, 9
    s_sub_u32 s33, s20, s33
    s_mul_i32 s24, s23, 9
    s_add_u32 s21, s21, s24
    s_cmp_ge_u32 s33, 6
    s_cselect_b32 s89, -2, 1
    s_add_u32 s89, s89, s21
    s_sub_u32 s34, s3, 1
    v_lshrrev_b32 v2, 4, v0
    v_and_b32 v3, 15, v0
    s_lshl_b32 s24, s34, 1
    s_and_b32 s24, s24, 4
    v_add_lshl_u32 v4, v2, s24, 1
    v_xor_b32 v4, v4, v3
    v_cmp_gt_u32 vcc, 8, v4
    v_and_b32 v4, 7, v4
    s_mul_i32 s24, s22, 192
    s_lshl_b32 s25, s34, 2
    s_add_u32 s24, s24, s25
    v_add_u32 v5, s24, v2
    s_movk_i32 s28, 9216
    v_mul_lo_u32 v6, v5, s28
    v_lshl_add_u32 v6, v4, 4, v6
    v_mov_b32 v7, s89
    v_mov_b32 v8, s21
    v_cndmask_b32 v7, v7, v8, vcc
    v_lshl_add_u32 v6, v7, 7, v6
    v_mov_b32 v7, 0
    s_mov_b32 s28, 294912
    s_mov_b32 s29, 0
    s_lshl_b32 s30, s34, 10
    s_add_u32 s30, s30, 2048
    s_mul_i32 s35, s23, 576
    s_mul_i32 s36, s32, 192
    s_add_u32 s35, s35, s36
    v_lshrrev_b32 v5, 3, v0
    s_lshl_b32 s36, s34, 3
    s_add_u32 s36, s36, s35
    v_add_u32 v10, s36, v5
    v_mul_u32_u24 v10, 1152, v10
    v_and_b32 v5, 2, v5
    s_and_b32 s36, s34, 1
    s_lshl_b32 s36, s36, 2
    v_or_b32 v5, s36, v5
    v_bitop3_b32 v5, v0, 7, v5 bitop3:0x6a
    v_lshl_add_u32 v10, v5, 4, v10
    s_lshl_b32 s36, s33, 7
    v_add_u32 v10, s36, v10
    s_waitcnt lgkmcnt(0)
    v_mov_b32 v8, s10
    v_mov_b32 v9, s11
    v_mov_b32 v11, s8
    v_mov_b32 v12, s9
    v_cndmask_b32 v8, v8, v11, vcc
    v_cndmask_b32 v9, v9, v12, vcc
    v_lshl_add_u64 v[8:9], v[6:7], 0, v[8:9]
    v_lshrrev_b32 v4, 2, v3
    v_and_b32 v5, 1, v2
    v_lshl_add_u32 v6, v5, 2, v4
    v_bfe_u32 v7, v3, 1, 1
    s_lshl_b32 s36, s34, 1
    v_add_u32 v7, s36, v7
    v_lshlrev_b32 v6, 1, v6
    v_xor_b32 v6, v6, v7
    v_lshl_add_u32 v13, v2, 3, v4
    v_and_b32 v14, 1, v3
    v_lshlrev_b32 v14, 3, v14
    v_lshl_add_u32 v11, v6, 4, v14
    v_lshl_add_u32 v11, v13, 8, v11
    v_add_u32 v11, 2048, v11
    v_and_b32 v4, 2, v4
    v_lshl_add_u32 v4, v5, 2, v4
    v_xor_b32 v4, v4, v7
    v_lshl_add_u32 v12, v4, 4, v14
    v_lshl_add_u32 v12, v13, 7, v12
    v_add_u32 v12, 51200, v12
    s_mov_b32 m0, s30
    s_nop 0
    global_load_lds_dwordx4 v[8:9], off nt
    s_add_u32 m0, s30, 8192
    v_lshl_add_u64 v[8:9], s[28:29], 0, v[8:9]
    global_load_lds_dwordx4 v[8:9], off nt
    v_and_b32 v4, 1, v0
    v_cmp_eq_u32 s[38:39], 1, v4
    v_mul_u32_u24 v4, 384, v4
    v_lshl_add_u32 v13, v2, 4, v4
    v_lshrrev_b32 v5, 1, v0
    s_lshl_b32 s36, s34, 6
    s_add_u32 s36, s36, 1024
    v_lshl_add_u32 v16, v5, 1, v4
    v_add_u32 v16, s36, v16
    s_lshl_b32 s36, s34, 5
    s_add_u32 s36, s36, s35
    s_lshr_b32 s37, s36, 6
    s_lshr_b32 s24, s37, 1
    s_lshl_b32 s24, s24, 14
    s_and_b32 s25, s37, 1
    s_lshl_b32 s25, s25, 12
    s_add_u32 s24, s24, s25
    s_and_b32 s36, s36, 63
    s_lshl_b32 s36, s36, 4
    s_add_u32 s24, s24, s36
    s_add_u32 s24, s24, 65536
    v_lshl_add_u32 v15, v5, 4, s24
    s_cmp_ge_u32 s34, 4
    s_cselect_b32 s37, s89, s21
    s_cselect_b32 s36, 8, 0
    s_lshr_b32 s24, s37, 1
    s_lshl_b32 s24, s24, 14
    s_and_b32 s25, s37, 1
    s_lshl_b32 s25, s25, 12
    s_add_u32 s24, s24, s25
    s_and_b32 s25, s34, 3
    s_lshl_b32 s25, s25, 8
    s_add_u32 s24, s24, s25
    s_lshl_b32 s25, s22, 10
    s_add_u32 s24, s24, s25
    s_add_u32 s24, s24, s36
    s_add_u32 s24, s24, 65536
    v_lshl_add_u32 v14, v3, 4, s24
    s_lshl_b32 s37, s33, 2
    s_add_u32 s37, s37, s34
    s_and_b32 s40, s37, 7
    s_lshr_b32 s24, s37, 1
    s_lshl_b32 s24, s24, 14
    s_and_b32 s25, s37, 1
    s_lshl_b32 s25, s25, 12
    s_add_u32 s24, s24, s25
    s_mul_i32 s25, s23, 3
    s_add_u32 s25, s25, s32
    s_lshl_b32 s25, s25, 7
    s_add_u32 s24, s24, s25
    s_add_u32 s24, s24, 655360
    v_lshl_add_u32 v17, v3, 3, s24
    v_mov_b32 v18, 0xffffffe0
    v_mov_b32 v19, 0
    s_mov_b32 s43, 0xbfb8aa3b
    s_and_b32 s44, s21, 7
    s_and_b32 s45, s89, 7
    s_cmp_eq_u32 s44, 3
    s_cselect_b32 s44, 3, s45
    s_cmp_eq_u32 s44, 3
    s_barrier
    ds_read_b32 v40, v19 offset:8
    s_cbranch_scc0 L_thr
    s_add_u32 m0, s30, 16384
    v_lshl_add_u64 v[8:9], s[28:29], 0, v[8:9]
    global_load_lds_dwordx4 v[8:9], off nt
    s_add_u32 m0, s30, 24576
    v_lshl_add_u64 v[8:9], s[28:29], 0, v[8:9]
    global_load_lds_dwordx4 v[8:9], off nt
    s_add_u32 m0, s30, 32768
    v_lshl_add_u64 v[8:9], s[28:29], 0, v[8:9]
    global_load_lds_dwordx4 v[8:9], off nt
    s_add_u32 m0, s30, 40960
    v_lshl_add_u64 v[8:9], s[28:29], 0, v[8:9]
    global_load_lds_dwordx4 v[8:9], off nt
    s_branch L_thrd
L_thr:
    s_add_u32 m0, s30, 16384
    v_lshl_add_u64 v[8:9], s[28:29], 0, v[8:9]
    global_load_lds_dwordx4 v[8:9], off nt
    s_waitcnt vmcnt(2)
    s_add_u32 m0, s30, 24576
    v_lshl_add_u64 v[8:9], s[28:29], 0, v[8:9]
    global_load_lds_dwordx4 v[8:9], off nt
    s_waitcnt vmcnt(2)
    s_add_u32 m0, s30, 32768
    v_lshl_add_u64 v[8:9], s[28:29], 0, v[8:9]
    global_load_lds_dwordx4 v[8:9], off nt
    s_waitcnt vmcnt(2)
    s_add_u32 m0, s30, 40960
    v_lshl_add_u64 v[8:9], s[28:29], 0, v[8:9]
    global_load_lds_dwordx4 v[8:9], off nt
L_thrd:
    s_waitcnt lgkmcnt(0)
    v_readfirstlane_b32 s36, v40
    s_and_b32 s92, s36, 31
    s_mov_b32 s94, s92
    s_lshr_b32 s93, s36, 5
    s_add_u32 s93, s93, s36
    s_and_b32 s93, s93, 31
    s_lshr_b32 s95, s36, 10
    s_add_u32 s95, s95, s36
    s_and_b32 s95, s95, 31
    s_cmp_ge_u32 s34, 4
    s_cselect_b32 s41, s95, s93
    v_mov_b32 v40, s93
    v_mov_b32 v41, s95
    v_cndmask_b32 v41, v40, v41, s[38:39]
    s_getpc_b64 s[60:61]
L_tpc:
    s_add_u32 s60, s60, L_tdone-L_tpc
    s_addc_u32 s61, s61, 0
    s_cmp_eq_u32 s3, 1
    s_cbranch_scc1 L_padB
    s_cmp_eq_u32 s3, 2
    s_cbranch_scc1 L_padA
L_tdone:
    s_waitcnt vmcnt(2)
    s_add_u32 m0, s30, 49152
    s_nop 0
    global_load_lds_dwordx4 v10, s[12:13] nt
    s_mov_b32 s37, 1048576
    s_waitcnt vmcnt(1)
    s_add_u32 m0, s30, 57344
    v_add_u32 v10, 73728, v10
    global_load_lds_dwordx4 v10, s[12:13] nt
    s_add_u32 m0, s30, 65536
    v_add_u32 v10, 73728, v10
    global_load_lds_dwordx4 v10, s[12:13] nt
    s_barrier
    ds_read_b64_tr_b16 v[44:45], v11 offset:0
    ds_read_b64_tr_b16 v[46:47], v11 offset:1024
    ds_read_b64_tr_b16 v[48:49], v11 offset:8192
    ds_read_b64_tr_b16 v[50:51], v11 offset:9216
    ds_read_b64_tr_b16 v[52:53], v11 offset:16384
    ds_read_b64_tr_b16 v[54:55], v11 offset:17408
    ds_read_b64_tr_b16 v[56:57], v11 offset:24576
    ds_read_b64_tr_b16 v[58:59], v11 offset:25600
    ds_read_b64_tr_b16 v[60:61], v11 offset:32768
    ds_read_b64_tr_b16 v[62:63], v11 offset:33792
    ds_read_b64_tr_b16 v[64:65], v11 offset:40960
    ds_read_b64_tr_b16 v[66:67], v11 offset:41984
    s_waitcnt lgkmcnt(0)
    s_branch L_psA
.fill 157, 4, 0xbf810000
L_padA:
    s_setpc_b64 s[60:61]
L_psA:
    s_barrier
    ds_read_b128 v[68:71], v13 offset:64
    ds_read_b128 v[72:75], v13 offset:128
    ds_read_b128 v[76:79], v13 offset:192
    ds_read_b128 v[80:83], v13 offset:256
    ds_read_b128 v[84:87], v13 offset:320
    ds_read_b128 v[88:91], v13 offset:384
    ds_read_b64 v[42:43], v19 offset:24
    s_waitcnt lgkmcnt(6)
    v_mfma_f32_16x16x32_bf16 v[20:23], v[68:71], v[44:47], 0
    s_waitcnt lgkmcnt(5)
    v_mfma_f32_16x16x32_bf16 v[20:23], v[72:75], v[48:51], v[20:23]
    s_waitcnt lgkmcnt(4)
    v_mfma_f32_16x16x32_bf16 v[20:23], v[76:79], v[52:55], v[20:23]
    s_waitcnt lgkmcnt(3)
    v_mfma_f32_16x16x32_bf16 v[20:23], v[80:83], v[56:59], v[20:23]
    s_waitcnt lgkmcnt(2)
    v_mfma_f32_16x16x32_bf16 v[20:23], v[84:87], v[60:63], v[20:23]
    s_waitcnt lgkmcnt(1)
    v_mfma_f32_16x16x32_bf16 v[20:23], v[88:91], v[64:67], v[20:23]
    s_waitcnt lgkmcnt(0)
    v_cmp_ne_u32 vcc, 0, v43
    v_bfe_u32 v42, v42, s40, 1
    v_lshl_add_u32 v17, v42, 13, v17
    s_mov_b64 exec, 0xffff
    s_nop 2
    v_and_or_b32 v20, v20, v18, s92
    v_and_or_b32 v21, v21, v18, s41
    s_cbranch_vccnz L_far
    global_store_dwordx2 v14, v[20:21], s[18:19]
L_pub:
    s_mov_b64 exec, -1
    s_waitcnt vmcnt(1)
    s_barrier
    s_cmp_gt_u32 s3, 6
    s_cbranch_scc1 L_b4
    global_load_dwordx4 v[28:31], v15, s[18:19] offset:0 sc1
    global_load_dwordx4 v[32:35], v15, s[18:19] offset:1024 sc1
    global_load_dwordx4 v[36:39], v15, s[18:19] offset:2048 sc1
    s_cmp_gt_u32 s3, 4
    s_cbranch_scc1 L_dchk
    ds_read_b64_tr_b16 v[44:45], v12 offset:0
    ds_read_b64_tr_b16 v[46:47], v12 offset:512
    ds_read_b64_tr_b16 v[48:49], v12 offset:4096
    ds_read_b64_tr_b16 v[50:51], v12 offset:4608
    ds_read_b64_tr_b16 v[52:53], v12 offset:8192
    ds_read_b64_tr_b16 v[54:55], v12 offset:8704
    ds_read_b64_tr_b16 v[56:57], v12 offset:12288
    ds_read_b64_tr_b16 v[58:59], v12 offset:12800
    ds_read_b64_tr_b16 v[60:61], v12 offset:16384
    ds_read_b64_tr_b16 v[62:63], v12 offset:16896
    ds_read_b64_tr_b16 v[64:65], v12 offset:20480
    ds_read_b64_tr_b16 v[66:67], v12 offset:20992
    s_branch L_dchk
L_dpoll:
    global_load_dwordx4 v[28:31], v15, s[18:19] offset:0 sc1
    global_load_dwordx4 v[32:35], v15, s[18:19] offset:1024 sc1
    global_load_dwordx4 v[36:39], v15, s[18:19] offset:2048 sc1
L_dchk:
    s_sub_u32 s37, s37, 1
    s_waitcnt vmcnt(2)
    v_xor_b32 v40, s92, v28
    v_bitop3_b32 v40, v29, s93, v40 bitop3:0xbe
    v_bitop3_b32 v40, v30, s94, v40 bitop3:0xbe
    v_bitop3_b32 v40, v31, s95, v40 bitop3:0xbe
    s_waitcnt vmcnt(1)
    v_bitop3_b32 v40, v32, s92, v40 bitop3:0xbe
    v_bitop3_b32 v40, v33, s93, v40 bitop3:0xbe
    v_bitop3_b32 v40, v34, s94, v40 bitop3:0xbe
    v_bitop3_b32 v40, v35, s95, v40 bitop3:0xbe
    v_pk_add_f32 v[4:5], v[28:29], v[32:33]
    v_pk_add_f32 v[6:7], v[30:31], v[34:35]
    s_waitcnt vmcnt(0)
    v_bitop3_b32 v40, v36, s92, v40 bitop3:0xbe
    v_bitop3_b32 v40, v37, s93, v40 bitop3:0xbe
    v_bitop3_b32 v40, v38, s94, v40 bitop3:0xbe
    v_bitop3_b32 v40, v39, s95, v40 bitop3:0xbe
    v_pk_add_f32 v[4:5], v[4:5], v[36:37]
    v_pk_add_f32 v[6:7], v[6:7], v[38:39]
    v_and_b32 v40, 31, v40
    v_cmp_ne_u32 vcc, 0, v40
    v_cndmask_b32 v4, v4, v5, s[38:39]
    v_cndmask_b32 v6, v6, v7, s[38:39]
    s_cbranch_scc1 L_dgo
    s_cbranch_vccnz L_dpoll
L_dgo:
    v_cvt_pk_bf16_f32 v4, v4, v6
    v_and_b32 v7, 0xffff0000, v4
    v_lshlrev_b32 v4, 16, v4
    v_mul_f32 v5, s43, v4
    v_exp_f32 v5, v5
    s_nop 0
    v_add_f32 v5, 1.0, v5
    v_rcp_f32 v5, v5
    s_nop 0
    v_mul_f32 v4, v4, v5
    v_cvt_pk_bf16_f32 v4, v4, v4
    v_and_b32 v4, 0xffff0000, v4
    v_mul_f32 v4, v4, v7
    v_cvt_pk_bf16_f32 v4, v4, v4
    ds_write_b16 v16, v4
    s_waitcnt lgkmcnt(0)
L_b4:
    s_barrier
    s_cmp_gt_u32 s3, 4
    s_cbranch_scc1 L_b5
    ds_read_b128 v[68:71], v13 offset:1024
    ds_read_b128 v[72:75], v13 offset:1088
    ds_read_b128 v[76:79], v13 offset:1152
    ds_read_b128 v[80:83], v13 offset:1216
    ds_read_b128 v[84:87], v13 offset:1280
    ds_read_b128 v[88:91], v13 offset:1344
    s_waitcnt lgkmcnt(5)
    v_mfma_f32_16x16x32_bf16 v[24:27], v[68:71], v[44:47], 0
    s_waitcnt lgkmcnt(4)
    v_mfma_f32_16x16x32_bf16 v[24:27], v[72:75], v[48:51], v[24:27]
    s_waitcnt lgkmcnt(3)
    v_mfma_f32_16x16x32_bf16 v[24:27], v[76:79], v[52:55], v[24:27]
    s_waitcnt lgkmcnt(2)
    v_mfma_f32_16x16x32_bf16 v[24:27], v[80:83], v[56:59], v[24:27]
    s_waitcnt lgkmcnt(1)
    v_mfma_f32_16x16x32_bf16 v[24:27], v[84:87], v[60:63], v[24:27]
    s_waitcnt lgkmcnt(0)
    v_mfma_f32_16x16x32_bf16 v[24:27], v[88:91], v[64:67], v[24:27]
    s_mov_b64 exec, 0xffff
    s_nop 6
    v_and_or_b32 v24, v24, v18, s92
    v_and_or_b32 v25, v25, v18, v41
    global_store_dwordx2 v17, v[24:25], s[18:19] sc1
    s_waitcnt vmcnt(0)
L_b5:
    s_barrier
    s_mov_b64 exec, 0xffff
    global_store_dwordx2 v14, v[20:21], s[18:19] sc1
L_end:
    s_endpgm
L_far:
    global_store_dwordx2 v14, v[20:21], s[18:19] sc1
    s_branch L_pub
L_r2:
    s_setprio 3
    v_mov_b32 v80, 0
    v_mov_b32 v81, 0
    v_mov_b32 v82, 0
    v_mov_b32 v83, 0
    v_sub_u32 v5, 2047, v3
    s_mov_b32 s25, 0xffff0000
    s_and_b32 s27, s2, 7
    s_lshl_b32 s27, s27, 5
    s_lshr_b32 s20, s2, 3
    s_add_u32 s27, s27, s20
    s_lshl_b32 s27, s27, 4
    s_add_u32 s27, s27, 16384
    v_mov_b32 v91, s27
    v_add_u32 v90, 4096, v91
    s_getreg_b32 s31, hwreg(HW_REG_XCC_ID, 0, 4)
    s_waitcnt vmcnt(9)
    ds_read_b128 v[44:47], v2 offset:64
    ds_read_b128 v[48:51], v2 offset:192
    ds_read_b128 v[52:55], v2 offset:320
    ds_read_b128 v[56:59], v2 offset:448
    ds_read_b128 v[60:63], v2 offset:576
    ds_read_b128 v[64:67], v2 offset:704
    ds_read_b128 v[68:71], v2 offset:832
    ds_read_b128 v[72:75], v2 offset:960
    ds_read_b128 v[76:79], v2 offset:1088
    v_readfirstlane_b32 s90, v6
    s_add_u32 s90, s90, 1
    s_mul_i32 s91, s90, 0x9e3779b1
    s_and_b32 s91, s91, 0xfffffff0
    s_or_b32 s31, s31, s91
    v_mov_b32 v86, s90
    v_mov_b32 v87, s31
    ds_write_b32 v7, v86 offset:8
    s_waitcnt lgkmcnt(0)
    s_waitcnt vmcnt(8)
    v_dot2c_f32_bf16 v80, v8, v44
    v_dot2c_f32_bf16 v81, v9, v45
    v_dot2c_f32_bf16 v82, v10, v46
    v_dot2c_f32_bf16 v83, v11, v47
    s_waitcnt vmcnt(7)
    v_dot2c_f32_bf16 v80, v12, v48
    v_dot2c_f32_bf16 v81, v13, v49
    v_dot2c_f32_bf16 v82, v14, v50
    v_dot2c_f32_bf16 v83, v15, v51
    s_waitcnt vmcnt(6)
    v_dot2c_f32_bf16 v80, v16, v52
    v_dot2c_f32_bf16 v81, v17, v53
    v_dot2c_f32_bf16 v82, v18, v54
    v_dot2c_f32_bf16 v83, v19, v55
    s_waitcnt vmcnt(5)
    v_dot2c_f32_bf16 v80, v20, v56
    v_dot2c_f32_bf16 v81, v21, v57
    v_dot2c_f32_bf16 v82, v22, v58
    v_dot2c_f32_bf16 v83, v23, v59
    s_waitcnt vmcnt(4)
    v_dot2c_f32_bf16 v80, v24, v60
    v_dot2c_f32_bf16 v81, v25, v61
    v_dot2c_f32_bf16 v82, v26, v62
    v_dot2c_f32_bf16 v83, v27, v63
    s_waitcnt vmcnt(3)
    v_dot2c_f32_bf16 v80, v28, v64
    v_dot2c_f32_bf16 v81, v29, v65
    v_dot2c_f32_bf16 v82, v30, v66
    v_dot2c_f32_bf16 v83, v31, v67
    s_waitcnt vmcnt(2)
    v_dot2c_f32_bf16 v80, v32, v68
    v_dot2c_f32_bf16 v81, v33, v69
    v_dot2c_f32_bf16 v82, v34, v70
    v_dot2c_f32_bf16 v83, v35, v71
    s_waitcnt vmcnt(1)
    v_dot2c_f32_bf16 v80, v36, v72
    v_dot2c_f32_bf16 v81, v37, v73
    v_dot2c_f32_bf16 v82, v38, v74
    v_dot2c_f32_bf16 v83, v39, v75
    s_waitcnt vmcnt(0)
    v_dot2c_f32_bf16 v80, v40, v76
    v_dot2c_f32_bf16 v81, v41, v77
    v_dot2c_f32_bf16 v82, v42, v78
    v_dot2c_f32_bf16 v83, v43, v79
    s_nop 2
    v_add_f32 v80, v80, v81
    v_add_f32 v82, v82, v83
    s_nop 0
    v_add_f32 v80, v80, v82
    s_nop 1
    v_add_f32_dpp v80, v80, v80 quad_perm:[1,0,3,2] row_mask:0xf bank_mask:0xf
    s_nop 1
    v_add_f32_dpp v80, v80, v80 quad_perm:[2,3,0,1] row_mask:0xf bank_mask:0xf
    s_nop 1
    v_add_f32_dpp v80, v80, v80 row_half_mirror row_mask:0xf bank_mask:0xf
    v_cvt_pk_bf16_f32 v81, v80, v80
    v_cmp_u_f32 vcc, v80, v80
    v_ashrrev_i32 v82, 31, v81
    v_or_b32 v82, 0x80000000, v82
    v_xor_b32 v81, v81, v82
    v_cndmask_b32 v81, v81, 0, vcc
    v_bfi_b32 v83, s25, v81, v5
    s_nop 1
    v_min_u32_dpp v85, v83, v83 row_ror:8 row_mask:0xf bank_mask:0xf
    v_max_u32_dpp v84, v83, v83 row_ror:8 row_mask:0xf bank_mask:0xf
    s_nop 0
    s_nop 0
    v_min_u32_dpp v82, v84, v84 row_bcast:15 row_mask:0xa bank_mask:0xf
    v_max_u32_dpp v85, v85, v85 row_bcast:15 row_mask:0xa bank_mask:0xf
    v_max_u32_dpp v84, v84, v84 row_bcast:15 row_mask:0xa bank_mask:0xf
    v_max_u32 v85, v85, v82
    s_nop 0
    v_min_u32_dpp v82, v84, v84 row_bcast:31 row_mask:0xc bank_mask:0xf
    v_max_u32_dpp v85, v85, v85 row_bcast:31 row_mask:0xc bank_mask:0xf
    v_max_u32_dpp v84, v84, v84 row_bcast:31 row_mask:0xc bank_mask:0xf
    v_max_u32 v85, v85, v82
    s_mov_b32 exec_lo, 0
    s_mov_b32 exec_hi, 0x80000000
    global_store_dwordx4 v91, v[84:87], s[18:19]
    global_store_dwordx4 v90, v[84:87], s[18:19] sc1
    s_mov_b64 exec, -1
    s_barrier
    s_movk_i32 s26, 0x207
    v_cmp_class_f32 vcc, v80, s26
    s_cbranch_vccnz L_fix
L_fixed:
    s_lshr_b32 s20, s2, 3
    s_mul_i32 s21, s20, 43
    s_lshr_b32 s21, s21, 7
    s_mul_i32 s22, s21, 3
    s_sub_u32 s22, s20, s22
    s_and_b32 s23, s2, 7
    s_mul_i32 s32, s20, 57
    s_lshr_b32 s32, s32, 9
    s_mul_i32 s33, s32, 9
    s_sub_u32 s33, s20, s33
    s_mov_b32 s96, s4
    s_mov_b32 s97, s5
    s_mov_b32 s98, 2359296
    s_mov_b32 s99, 0x00020000
    v_subrev_u32 v92, 24, v0
    v_min_u32 v92, v92, v0
    v_lshlrev_b32 v92, 4, v92
    s_mul_i32 s24, s22, 384
    v_add_u32 v92, s24, v92
    s_lshl_b32 s24, s33, 4
    s_sub_u32 s24, s27, s24
    s_add_u32 s24, s24, 4096
    v_lshl_add_u32 v93, v0, 4, s24
    s_lshl_b32 s24, s20, 7
    s_add_u32 s24, s24, 32768
    s_add_u32 s20, s18, s24
    s_addc_u32 s21, s19, 0
    s_and_b32 s24, s2, 4
    s_lshl_b32 s24, s24, 11
    s_add_u32 s100, s20, s24
    s_addc_u32 s101, s21, 0
    s_mov_b32 s88, 0
    s_mov_b32 s89, 15
    s_mov_b32 s29, 1048576
    s_mov_b64 exec, 0x1ff
    s_branch L_psB
.fill 70, 4, 0xbf810000
L_padB:
    s_setpc_b64 s[60:61]
L_psB:
    s_lshl_b32 m0, s23, 2
L_rp1:
    s_load_dwordx16 s[32:47], s[100:101], 0 glc
    s_load_dwordx16 s[48:63], s[100:101], 64 glc
    s_sub_u32 s29, s29, 1
    s_cbranch_scc1 L_rto
    s_waitcnt lgkmcnt(0)
    s_xor_b64 s[24:25], s[34:35], s[90:91]
    s_xor_b64 s[26:27], s[38:39], s[90:91]
    s_or_b64 s[24:25], s[24:25], s[26:27]
    s_xor_b64 s[26:27], s[42:43], s[90:91]
    s_or_b64 s[24:25], s[24:25], s[26:27]
    s_xor_b64 s[26:27], s[46:47], s[90:91]
    s_or_b64 s[24:25], s[24:25], s[26:27]
    s_xor_b64 s[26:27], s[50:51], s[90:91]
    s_or_b64 s[24:25], s[24:25], s[26:27]
    s_xor_b64 s[26:27], s[54:55], s[90:91]
    s_or_b64 s[24:25], s[24:25], s[26:27]
    s_xor_b64 s[26:27], s[58:59], s[90:91]
    s_or_b64 s[24:25], s[24:25], s[26:27]
    s_xor_b64 s[26:27], s[62:63], s[90:91]
    s_or_b64 s[24:25], s[24:25], s[26:27]
    s_andn2_b64 s[24:25], s[24:25], s[88:89]
    s_cbranch_scc0 L_rto
    s_movrels_b32 s24, s35
    s_xor_b32 s25, s24, s91
    s_cmp_lt_u32 s25, 16
    s_cbranch_scc0 L_rp1
    s_bfe_u32 s24, s24, 0x10002
    s_lshl_b32 s24, s24, 13
    s_add_u32 s100, s20, s24
    s_addc_u32 s101, s21, 0
L_rpoll:
    s_load_dwordx16 s[32:47], s[100:101], 0 glc
    s_load_dwordx16 s[48:63], s[100:101], 64 glc
    s_sub_u32 s29, s29, 1
    s_cbranch_scc1 L_rto
    s_waitcnt lgkmcnt(0)
    s_xor_b64 s[24:25], s[34:35], s[90:91]
    s_xor_b64 s[26:27], s[38:39], s[90:91]
    s_or_b64 s[24:25], s[24:25], s[26:27]
    s_xor_b64 s[26:27], s[42:43], s[90:91]
    s_or_b64 s[24:25], s[24:25], s[26:27]
    s_xor_b64 s[26:27], s[46:47], s[90:91]
    s_or_b64 s[24:25], s[24:25], s[26:27]
    s_xor_b64 s[26:27], s[50:51], s[90:91]
    s_or_b64 s[24:25], s[24:25], s[26:27]
    s_xor_b64 s[26:27], s[54:55], s[90:91]
    s_or_b64 s[24:25], s[24:25], s[26:27]
    s_xor_b64 s[26:27], s[58:59], s[90:91]
    s_or_b64 s[24:25], s[24:25], s[26:27]
    s_xor_b64 s[26:27], s[62:63], s[90:91]
    s_or_b64 s[24:25], s[24:25], s[26:27]
    s_andn2_b64 s[24:25], s[24:25], s[88:89]
    s_cbranch_scc1 L_rpoll
L_rto:
    s_waitcnt lgkmcnt(0)
    global_load_dwordx2 v[62:63], v93, s[18:19] offset:8 sc1
    s_mov_b32 exec_lo, 0x00ffffff
    s_min_u32 s34, s32, s36
    s_max_u32 s32, s32, s36
    s_max_u32 s33, s33, s37
    s_max_u32 s33, s33, s34
    s_min_u32 s34, s32, s40
    s_max_u32 s32, s32, s40
    s_max_u32 s33, s33, s41
    s_max_u32 s33, s33, s34
    s_min_u32 s34, s32, s44
    s_max_u32 s32, s32, s44
    s_max_u32 s33, s33, s45
    s_max_u32 s33, s33, s34
    s_min_u32 s34, s32, s48
    s_max_u32 s32, s32, s48
    s_max_u32 s33, s33, s49
    s_max_u32 s33, s33, s34
    s_min_u32 s34, s32, s52
    s_max_u32 s32, s32, s52
    s_max_u32 s33, s33, s53
    s_max_u32 s33, s33, s34
    s_min_u32 s34, s32, s56
    s_max_u32 s32, s32, s56
    s_max_u32 s33, s33, s57
    s_max_u32 s33, s33, s34
    s_min_u32 s34, s32, s60
    s_max_u32 s32, s32, s60
    s_max_u32 s33, s33, s61
    s_max_u32 s33, s33, s34
    s_mov_b32 m0, 64
    s_mov_b32 s24, s35
    s_andn2_b32 s34, 0x7ff, s32
    s_andn2_b32 s35, 0x7ff, s33
    s_mul_i32 s34, s34, 1152
    s_mul_i32 s35, s35, 1152
    s_cmp_ge_u32 s2, 216
    s_cbranch_scc1 L_rnf
    buffer_load_dwordx4 v92, s[96:99], s34 offen lds
    s_mov_b32 exec_lo, 0xff000000
    s_mov_b32 exec_hi, 0x0000ffff
    buffer_load_dwordx4 v92, s[96:99], s35 offen lds
    s_barrier
    s_call_b64 s[30:31], L_votes
    s_mov_b64 exec, 0x1ff
    s_waitcnt vmcnt(2)
    v_xor_b32 v62, v62, v86
    v_xor_b32 v63, v63, v87
    v_or_b32 v62, v62, v63
    v_cmp_ne_u32 vcc, 0, v62
    v_mov_b32 v60, s38
    s_nop 0
    v_mov_b32 v61, vcc_lo
    ds_write_b64 v7, v[60:61] offset:24
    s_waitcnt vmcnt(0) lgkmcnt(0)
    s_barrier
    s_barrier
    s_barrier
L_late:
    s_mov_b64 exec, -1
    v_cmp_gt_u32 vcc, s33, v83
    s_mov_b64 exec, vcc
    global_store_dwordx4 v4, v[8:11], s[14:15] offset:0 sc1
    global_store_dwordx4 v4, v[12:15], s[14:15] offset:128 sc1
    global_store_dwordx4 v4, v[16:19], s[14:15] offset:256 sc1
    global_store_dwordx4 v4, v[20:23], s[14:15] offset:384 sc1
    global_store_dwordx4 v4, v[24:27], s[14:15] offset:512 sc1
    global_store_dwordx4 v4, v[28:31], s[14:15] offset:640 sc1
    global_store_dwordx4 v4, v[32:35], s[14:15] offset:768 sc1
    global_store_dwordx4 v4, v[36:39], s[14:15] offset:896 sc1
    global_store_dwordx4 v4, v[40:43], s[14:15] offset:1024 sc1
    s_mov_b32 exec_lo, 0
    s_mov_b32 exec_hi, 0x80000000
    global_store_dwordx4 v91, v[84:87], s[18:19] sc1
    s_endpgm
L_votes:
    s_and_b32 s26, s24, 1
    s_bfe_u32 s27, s24, 0x10001
    s_and_b32 s25, s39, 1
    s_add_u32 s26, s26, s25
    s_bfe_u32 s25, s39, 0x10001
    s_lshl_b32 s25, s25, 1
    s_or_b32 s27, s27, s25
    s_and_b32 s25, s43, 1
    s_add_u32 s26, s26, s25
    s_bfe_u32 s25, s43, 0x10001
    s_lshl_b32 s25, s25, 2
    s_or_b32 s27, s27, s25
    s_and_b32 s25, s47, 1
    s_add_u32 s26, s26, s25
    s_bfe_u32 s25, s47, 0x10001
    s_lshl_b32 s25, s25, 3
    s_or_b32 s27, s27, s25
    s_and_b32 s25, s51, 1
    s_add_u32 s26, s26, s25
    s_bfe_u32 s25, s51, 0x10001
    s_lshl_b32 s25, s25, 4
    s_or_b32 s27, s27, s25
    s_and_b32 s25, s55, 1
    s_add_u32 s26, s26, s25
    s_bfe_u32 s25, s55, 0x10001
    s_lshl_b32 s25, s25, 5
    s_or_b32 s27, s27, s25
    s_and_b32 s25, s59, 1
    s_add_u32 s26, s26, s25
    s_bfe_u32 s25, s59, 0x10001
    s_lshl_b32 s25, s25, 6
    s_or_b32 s27, s27, s25
    s_and_b32 s25, s63, 1
    s_add_u32 s26, s26, s25
    s_bfe_u32 s25, s63, 0x10001
    s_lshl_b32 s25, s25, 7
    s_or_b32 s27, s27, s25
    s_cmp_gt_u32 s26, 4
    s_cselect_b32 s38, 0xff, 0
    s_xor_b32 s38, s38, s27
    s_setpc_b64 s[30:31]
L_rnf:
    s_call_b64 s[30:31], L_votes
    s_mov_b64 exec, 1
    v_mov_b32 v64, s38
    ds_write_b32 v7, v64 offset:12
    s_cmp_lg_u32 s2, 255
    s_cbranch_scc1 L_nobump
    global_store_dword v7, v86, s[18:19] sc1
L_nobump:
    v_mov_b32 v60, s34
    v_mov_b32 v61, s35
    v_mov_b32 v66, s32
    v_mov_b32 v67, s33
    ds_write_b64 v7, v[60:61] offset:0
    ds_write_b64 v7, v[66:67] offset:16
    s_waitcnt lgkmcnt(0)
    s_barrier
    s_branch L_late
L_red:
    s_cmp_le_u32 s3, 2
    s_cbranch_scc1 L_red1
    s_cmp_eq_u32 s3, 3
    s_cbranch_scc1 L_ld
    s_lshr_b32 s24, s2, 3
    s_lshl_b32 s24, s24, 4
    s_add_u32 s24, s24, s3
    s_cmp_eq_u32 s24, 453
    s_cbranch_scc1 L_ms
    s_cmp_lg_u32 s24, 436
    s_cbranch_scc1 L_end2
    s_and_b32 s23, s2, 7
    s_mul_i32 s23, s23, 9
    s_mov_b32 s25, 65536
    v_lshl_add_u32 v1, v0, 7, s25
    s_mov_b64 exec, 0xffffff
    s_mov_b32 s26, 9
    s_waitcnt lgkmcnt(0)
L_wml:
    s_lshr_b32 s24, s23, 1
    s_lshl_b32 s24, s24, 14
    s_and_b32 s27, s23, 1
    s_lshl_b32 s27, s27, 12
    s_add_u32 s24, s24, s27
    v_add_u32 v2, s24, v1
    global_load_dword v3, v2, s[18:19] sc1
    s_add_u32 s23, s23, 1
    s_sub_u32 s26, s26, 1
    s_cmp_lg_u32 s26, 0
    s_cbranch_scc1 L_wml
    s_endpgm
L_ld:
    s_cmp_lt_u32 s2, 240
    s_cbranch_scc1 L_end2
    s_and_b32 s23, s2, 7
    s_cmp_ge_u32 s2, 248
    s_cselect_b32 s24, 4, 5
    s_lshl_b32 s24, s24, 12
    s_lshl_b32 s25, s23, 9
    s_add_u32 s24, s24, s25
    v_and_b32 v1, 31, v0
    v_lshl_add_u32 v1, v1, 4, s24
    s_lshl_b32 s25, s23, 4
    s_add_u32 s25, s25, 32768
    v_lshl_add_u32 v2, v0, 7, s25
    v_lshrrev_b32 v3, 5, v0
    v_lshl_add_u32 v2, v3, 12, v2
    v_mov_b32 v6, 0
    s_waitcnt lgkmcnt(0)
    global_load_dword v8, v1, s[18:19] sc1
    s_barrier
    ds_read_b32 v9, v6 offset:8
    s_waitcnt lgkmcnt(0)
    v_readfirstlane_b32 s36, v9
    s_mul_i32 s37, s36, 0x9e3779b1
    s_and_b32 s37, s37, 0xfffffff0
    s_cmp_ge_u32 s2, 248
    s_movk_i32 s29, 96
    s_cselect_b32 s29, s29, 1048576
L_lpoll:
    global_load_dwordx4 v[8:11], v1, s[18:19] sc1
    s_sub_u32 s29, s29, 1
    s_waitcnt vmcnt(0)
    v_xor_b32 v12, s37, v11
    v_and_b32 v12, 0xfffffff0, v12
    v_bitop3_b32 v12, v10, s36, v12 bitop3:0xbe
    v_cmp_ne_u32 vcc, 0, v12
    s_cbranch_scc1 L_end2
    s_cbranch_vccnz L_lpoll
    s_nop 0
    v_min_u32_dpp v12, v8, v8 row_ror:8 row_mask:0xf bank_mask:0xf
    v_max_u32_dpp v9, v9, v9 row_ror:8 row_mask:0xf bank_mask:0xf
    v_max_u32_dpp v8, v8, v8 row_ror:8 row_mask:0xf bank_mask:0xf
    v_max_u32 v9, v9, v12
    s_nop 0
    v_min_u32_dpp v12, v8, v8 row_ror:4 row_mask:0xf bank_mask:0xf
    v_max_u32_dpp v9, v9, v9 row_ror:4 row_mask:0xf bank_mask:0xf
    v_max_u32_dpp v8, v8, v8 row_ror:4 row_mask:0xf bank_mask:0xf
    v_max_u32 v9, v9, v12
    s_nop 0
    v_min_u32_dpp v12, v8, v8 row_ror:2 row_mask:0xf bank_mask:0xf
    v_max_u32_dpp v9, v9, v9 row_ror:2 row_mask:0xf bank_mask:0xf
    v_max_u32_dpp v8, v8, v8 row_ror:2 row_mask:0xf bank_mask:0xf
    v_max_u32 v9, v9, v12
    s_nop 0
    v_min_u32_dpp v12, v8, v8 row_ror:1 row_mask:0xf bank_mask:0xf
    v_max_u32_dpp v9, v9, v9 row_ror:1 row_mask:0xf bank_mask:0xf
    v_max_u32_dpp v8, v8, v8 row_ror:1 row_mask:0xf bank_mask:0xf
    v_max_u32 v9, v9, v12
    v_mov_b32 v12, v8
    v_mov_b32 v13, v9
    s_nop 1
    v_permlane16_swap_b32 v8, v12
    v_permlane16_swap_b32 v9, v13
    s_nop 1
    v_min_u32 v14, v8, v12
    v_max_u32 v8, v8, v12
    v_max3_u32 v9, v9, v13, v14
    global_store_dwordx3 v2, v[8:10], s[18:19] sc1
L_end2:
    s_endpgm
L_ms:
    s_and_b32 s24, s2, 7
    s_lshl_b32 s25, s24, 7
    s_add_u32 s25, s25, 4096
    s_getreg_b32 s27, hwreg(HW_REG_XCC_ID, 2, 1)
    v_mov_b32 v6, 0
    s_waitcnt lgkmcnt(0)
    global_load_dword v10, v6, s[18:19] sc1
    s_add_u32 s30, s18, s25
    s_addc_u32 s31, s19, 0
    s_load_dword s35, s[30:31], 0 glc
    s_load_dword s34, s[30:31], 0x2000 glc
    s_waitcnt lgkmcnt(0)
    s_memtime s[36:37]
    s_load_dword s35, s[30:31], 0 glc
    s_waitcnt lgkmcnt(0)
    s_memtime s[38:39]
    s_load_dword s35, s[30:31], 0x2000 glc
    s_waitcnt lgkmcnt(0)
    s_memtime s[40:41]
    s_waitcnt lgkmcnt(0)
    s_sub_u32 s32, s38, s36
    s_sub_u32 s33, s40, s38
    s_cmp_lt_u32 s33, s32
    s_cselect_b32 s33, 5, 0
    s_mul_i32 s27, s27, 3
    s_xor_b32 s33, s33, s27
    s_lshl_b32 s26, s24, 4
    s_add_u32 s26, s26, 32780
    v_lshl_add_u32 v8, v0, 7, s26
    v_lshrrev_b32 v9, 5, v0
    v_lshl_add_u32 v8, v9, 12, v8
    s_waitcnt vmcnt(0)
    v_readfirstlane_b32 s34, v10
    s_add_u32 s34, s34, 1
    s_mul_i32 s34, s34, 0x9e3779b1
    s_and_b32 s34, s34, 0xfffffff0
    s_or_b32 s34, s34, s33
    v_mov_b32 v11, s34
    global_store_dword v8, v11, s[18:19] sc1
    s_endpgm
L_red1:
    s_cmp_eq_u32 s3, 1
    s_movk_i32 s25, 216
    s_cselect_b32 s25, s25, 208
    s_cselect_b32 s26, 0, 32
    s_cselect_b32 s27, 32, 36
    s_sub_u32 s24, s2, s25
    s_cmp_lt_u32 s24, s26
    s_cbranch_scc1 L_end2
    s_cmp_ge_u32 s24, s27
    s_cbranch_scc1 L_end2
    s_lshr_b32 s25, s24, 1
    s_lshl_b32 s25, s25, 14
    s_and_b32 s26, s24, 1
    s_lshl_b32 s26, s26, 12
    s_add_u32 s25, s25, s26
    s_add_u32 s25, s25, 655360
    v_lshl_add_u32 v1, v0, 4, s25
    v_bfe_u32 v4, v0, 4, 1
    v_and_b32 v5, 7, v0
    v_lshl_add_u32 v4, v5, 1, v4
    s_lshl_b32 s26, s24, 4
    v_add_lshl_u32 v4, v4, s26, 1
    v_lshrrev_b32 v5, 5, v0
    v_lshlrev_b32 v5, 2, v5
    v_mov_b32 v6, 0
    s_waitcnt lgkmcnt(0)
    s_and_b32 s26, s24, 7
    s_barrier
    s_call_b64 s[60:61], L_padB
    s_call_b64 s[60:61], L_padD
    s_barrier
    ds_read_b32 v8, v5 offset:0
    ds_read_b32 v7, v5 offset:16
    ds_read_b32 v9, v6 offset:8
    ds_read_b32 v11, v6 offset:12
    s_waitcnt lgkmcnt(0)
    v_add_u32 v4, v4, v8
    v_bfe_u32 v11, v11, s26, 1
    v_lshl_add_u32 v1, v11, 13, v1
    global_load_ushort v10, v4, s[4:5]
    v_readfirstlane_b32 s36, v9
    s_and_b32 s92, s36, 31
    s_mov_b32 s94, s92
    s_lshr_b32 s93, s36, 5
    s_add_u32 s93, s93, s36
    s_and_b32 s93, s93, 31
    s_lshr_b32 s95, s36, 10
    s_add_u32 s95, s95, s36
    s_and_b32 s95, s95, 31
    v_ashrrev_i32 v8, 31, v7
    v_not_b32 v8, v8
    v_or_b32 v8, 0x80000000, v8
    v_xor_b32 v7, v7, v8
    v_and_b32 v7, 0xffff0000, v7
    v_mul_f32 v7, 0xbfb8aa3b, v7
    v_exp_f32 v7, v7
    s_nop 0
    v_add_f32 v7, 1.0, v7
    v_rcp_f32 v7, v7
    s_nop 0
    v_cvt_pk_bf16_f32 v7, v7, v7
    v_and_b32 v7, 0xffff0000, v7
    s_waitcnt vmcnt(0)
    v_lshlrev_b32 v10, 16, v10
    s_mov_b32 s37, 1048576
    s_branch L_psD
L_padD:
    s_setpc_b64 s[60:61]
L_psD:
    global_load_dwordx4 v[16:19], v1, s[18:19] offset:0 sc1
    global_load_dwordx4 v[20:23], v1, s[18:19] offset:1024 sc1
    global_load_dwordx4 v[24:27], v1, s[18:19] offset:2048 sc1
L_ppoll:
    global_load_dwordx4 v[28:31], v1, s[18:19] offset:0 sc1
    global_load_dwordx4 v[32:35], v1, s[18:19] offset:1024 sc1
    global_load_dwordx4 v[36:39], v1, s[18:19] offset:2048 sc1
    s_sub_u32 s37, s37, 1
    s_waitcnt vmcnt(5)
    v_xor_b32 v11, s92, v16
    v_bitop3_b32 v11, v17, s93, v11 bitop3:0xbe
    v_bitop3_b32 v11, v18, s94, v11 bitop3:0xbe
    v_bitop3_b32 v11, v19, s95, v11 bitop3:0xbe
    s_waitcnt vmcnt(4)
    v_bitop3_b32 v11, v20, s92, v11 bitop3:0xbe
    v_bitop3_b32 v11, v21, s93, v11 bitop3:0xbe
    v_bitop3_b32 v11, v22, s94, v11 bitop3:0xbe
    v_bitop3_b32 v11, v23, s95, v11 bitop3:0xbe
    v_pk_add_f32 v[12:13], v[16:17], v[20:21]
    v_pk_add_f32 v[14:15], v[18:19], v[22:23]
    s_waitcnt vmcnt(3)
    v_bitop3_b32 v11, v24, s92, v11 bitop3:0xbe
    v_bitop3_b32 v11, v25, s93, v11 bitop3:0xbe
    v_bitop3_b32 v11, v26, s94, v11 bitop3:0xbe
    v_bitop3_b32 v11, v27, s95, v11 bitop3:0xbe
    v_pk_add_f32 v[12:13], v[12:13], v[24:25]
    v_pk_add_f32 v[14:15], v[14:15], v[26:27]
    v_and_b32 v11, 31, v11
    v_cmp_ne_u32 vcc, 0, v11
    s_cbranch_scc1 L_pgo
    s_cbranch_vccz L_pgo
    global_load_dwordx4 v[16:19], v1, s[18:19] offset:0 sc1
    global_load_dwordx4 v[20:23], v1, s[18:19] offset:1024 sc1
    global_load_dwordx4 v[24:27], v1, s[18:19] offset:2048 sc1
    s_waitcnt vmcnt(5)
    v_xor_b32 v11, s92, v28
    v_bitop3_b32 v11, v29, s93, v11 bitop3:0xbe
    v_bitop3_b32 v11, v30, s94, v11 bitop3:0xbe
    v_bitop3_b32 v11, v31, s95, v11 bitop3:0xbe
    s_waitcnt vmcnt(4)
    v_bitop3_b32 v11, v32, s92, v11 bitop3:0xbe
    v_bitop3_b32 v11, v33, s93, v11 bitop3:0xbe
    v_bitop3_b32 v11, v34, s94, v11 bitop3:0xbe
    v_bitop3_b32 v11, v35, s95, v11 bitop3:0xbe
    v_pk_add_f32 v[12:13], v[28:29], v[32:33]
    v_pk_add_f32 v[14:15], v[30:31], v[34:35]
    s_waitcnt vmcnt(3)
    v_bitop3_b32 v11, v36, s92, v11 bitop3:0xbe
    v_bitop3_b32 v11, v37, s93, v11 bitop3:0xbe
    v_bitop3_b32 v11, v38, s94, v11 bitop3:0xbe
    v_bitop3_b32 v11, v39, s95, v11 bitop3:0xbe
    v_pk_add_f32 v[12:13], v[12:13], v[36:37]
    v_pk_add_f32 v[14:15], v[14:15], v[38:39]
    v_and_b32 v11, 31, v11
    v_cmp_ne_u32 vcc, 0, v11
    s_cbranch_vccnz L_ppoll
L_pgo:
    v_permlane32_swap_b32 v12, v13
    v_permlane32_swap_b32 v14, v15
    s_nop 1
    v_add_f32 v12, v12, v13
    v_add_f32 v14, v14, v15
    s_nop 1
    v_permlane16_swap_b32 v12, v14
    s_nop 1
    v_add_f32 v12, v12, v14
    s_nop 1
    v_add_f32_dpp v12, v12, v12 row_ror:8 row_mask:0xf bank_mask:0xf
    v_cvt_pk_bf16_f32 v12, v12, v12
    v_and_b32 v12, 0xffff0000, v12
    v_mul_f32 v12, v12, v7
    v_cvt_pk_bf16_f32 v12, v12, v12
    v_and_b32 v12, 0xffff0000, v12
    v_fma_f32 v12, v10, 0, v12
    v_add_f32 v12, v10, v12
    v_cvt_pk_bf16_f32 v12, v12, v12
    s_mov_b32 exec_lo, 0x00ff00ff
    s_mov_b32 exec_hi, 0x00ff00ff
    global_store_short v4, v12, s[14:15] sc1
L_end3:
    s_endpgm
L_fix:
    s_mov_b32 s30, 0x7f807f80
    s_mov_b32 s36, 0x00400040
    v_and_b32 v88, s30, v8
    v_add_u32 v88, 0x00800080, v88
    v_lshrrev_b32 v88, 9, v88
    v_and_or_b32 v8, v88, s36, v8
    v_and_b32 v88, s30, v9
    v_add_u32 v88, 0x00800080, v88
    v_lshrrev_b32 v88, 9, v88
    v_and_or_b32 v9, v88, s36, v9
    v_and_b32 v88, s30, v10
    v_add_u32 v88, 0x00800080, v88
    v_lshrrev_b32 v88, 9, v88
    v_and_or_b32 v10, v88, s36, v10
    v_and_b32 v88, s30, v11
    v_add_u32 v88, 0x00800080, v88
    v_lshrrev_b32 v88, 9, v88
    v_and_or_b32 v11, v88, s36, v11
    v_and_b32 v88, s30, v12
    v_add_u32 v88, 0x00800080, v88
    v_lshrrev_b32 v88, 9, v88
    v_and_or_b32 v12, v88, s36, v12
    v_and_b32 v88, s30, v13
    v_add_u32 v88, 0x00800080, v88
    v_lshrrev_b32 v88, 9, v88
    v_and_or_b32 v13, v88, s36, v13
    v_and_b32 v88, s30, v14
    v_add_u32 v88, 0x00800080, v88
    v_lshrrev_b32 v88, 9, v88
    v_and_or_b32 v14, v88, s36, v14
    v_and_b32 v88, s30, v15
    v_add_u32 v88, 0x00800080, v88
    v_lshrrev_b32 v88, 9, v88
    v_and_or_b32 v15, v88, s36, v15
    v_and_b32 v88, s30, v16
    v_add_u32 v88, 0x00800080, v88
    v_lshrrev_b32 v88, 9, v88
    v_and_or_b32 v16, v88, s36, v16
    v_and_b32 v88, s30, v17
    v_add_u32 v88, 0x00800080, v88
    v_lshrrev_b32 v88, 9, v88
    v_and_or_b32 v17, v88, s36, v17
    v_and_b32 v88, s30, v18
    v_add_u32 v88, 0x00800080, v88
    v_lshrrev_b32 v88, 9, v88
    v_and_or_b32 v18, v88, s36, v18
    v_and_b32 v88, s30, v19
    v_add_u32 v88, 0x00800080, v88
    v_lshrrev_b32 v88, 9, v88
    v_and_or_b32 v19, v88, s36, v19
    v_and_b32 v88, s30, v20
    v_add_u32 v88, 0x00800080, v88
    v_lshrrev_b32 v88, 9, v88
    v_and_or_b32 v20, v88, s36, v20
    v_and_b32 v88, s30, v21
    v_add_u32 v88, 0x00800080, v88
    v_lshrrev_b32 v88, 9, v88
    v_and_or_b32 v21, v88, s36, v21
    v_and_b32 v88, s30, v22
    v_add_u32 v88, 0x00800080, v88
    v_lshrrev_b32 v88, 9, v88
    v_and_or_b32 v22, v88, s36, v22
    v_and_b32 v88, s30, v23
    v_add_u32 v88, 0x00800080, v88
    v_lshrrev_b32 v88, 9, v88
    v_and_or_b32 v23, v88, s36, v23
    v_and_b32 v88, s30, v24
    v_add_u32 v88, 0x00800080, v88
    v_lshrrev_b32 v88, 9, v88
    v_and_or_b32 v24, v88, s36, v24
    v_and_b32 v88, s30, v25
    v_add_u32 v88, 0x00800080, v88
    v_lshrrev_b32 v88, 9, v88
    v_and_or_b32 v25, v88, s36, v25
    v_and_b32 v88, s30, v26
    v_add_u32 v88, 0x00800080, v88
    v_lshrrev_b32 v88, 9, v88
    v_and_or_b32 v26, v88, s36, v26
    v_and_b32 v88, s30, v27
    v_add_u32 v88, 0x00800080, v88
    v_lshrrev_b32 v88, 9, v88
    v_and_or_b32 v27, v88, s36, v27
    v_and_b32 v88, s30, v28
    v_add_u32 v88, 0x00800080, v88
    v_lshrrev_b32 v88, 9, v88
    v_and_or_b32 v28, v88, s36, v28
    v_and_b32 v88, s30, v29
    v_add_u32 v88, 0x00800080, v88
    v_lshrrev_b32 v88, 9, v88
    v_and_or_b32 v29, v88, s36, v29
    v_and_b32 v88, s30, v30
    v_add_u32 v88, 0x00800080, v88
    v_lshrrev_b32 v88, 9, v88
    v_and_or_b32 v30, v88, s36, v30
    v_and_b32 v88, s30, v31
    v_add_u32 v88, 0x00800080, v88
    v_lshrrev_b32 v88, 9, v88
    v_and_or_b32 v31, v88, s36, v31
    v_and_b32 v88, s30, v32
    v_add_u32 v88, 0x00800080, v88
    v_lshrrev_b32 v88, 9, v88
    v_and_or_b32 v32, v88, s36, v32
    v_and_b32 v88, s30, v33
    v_add_u32 v88, 0x00800080, v88
    v_lshrrev_b32 v88, 9, v88
    v_and_or_b32 v33, v88, s36, v33
    v_and_b32 v88, s30, v34
    v_add_u32 v88, 0x00800080, v88
    v_lshrrev_b32 v88, 9, v88
    v_and_or_b32 v34, v88, s36, v34
    v_and_b32 v88, s30, v35
    v_add_u32 v88, 0x00800080, v88
    v_lshrrev_b32 v88, 9, v88
    v_and_or_b32 v35, v88, s36, v35
    v_and_b32 v88, s30, v36
    v_add_u32 v88, 0x00800080, v88
    v_lshrrev_b32 v88, 9, v88
    v_and_or_b32 v36, v88, s36, v36
    v_and_b32 v88, s30, v37
    v_add_u32 v88, 0x00800080, v88
    v_lshrrev_b32 v88, 9, v88
    v_and_or_b32 v37, v88, s36, v37
    v_and_b32 v88, s30, v38
    v_add_u32 v88, 0x00800080, v88
    v_lshrrev_b32 v88, 9, v88
    v_and_or_b32 v38, v88, s36, v38
    v_and_b32 v88, s30, v39
    v_add_u32 v88, 0x00800080, v88
    v_lshrrev_b32 v88, 9, v88
    v_and_or_b32 v39, v88, s36, v39
    v_and_b32 v88, s30, v40
    v_add_u32 v88, 0x00800080, v88
    v_lshrrev_b32 v88, 9, v88
    v_and_or_b32 v40, v88, s36, v40
    v_and_b32 v88, s30, v41
    v_add_u32 v88, 0x00800080, v88
    v_lshrrev_b32 v88, 9, v88
    v_and_or_b32 v41, v88, s36, v41
    v_and_b32 v88, s30, v42
    v_add_u32 v88, 0x00800080, v88
    v_lshrrev_b32 v88, 9, v88
    v_and_or_b32 v42, v88, s36, v42
    v_and_b32 v88, s30, v43
    v_add_u32 v88, 0x00800080, v88
    v_lshrrev_b32 v88, 9, v88
    v_and_or_b32 v43, v88, s36, v43
    s_branch L_fixed
.section .rodata,"a"
.p2align 6
.amdhsa_kernel standalone__moe_arch_mod__prompt_kernel
  .amdhsa_next_free_vgpr 96
  .amdhsa_next_free_sgpr 102
  .amdhsa_accum_offset 96
  .amdhsa_group_segment_fixed_size 0
  .amdhsa_kernarg_size 64
  .amdhsa_user_sgpr_count 2
  .amdhsa_user_sgpr_kernarg_segment_ptr 1
  .amdhsa_system_sgpr_workgroup_id_x 1
  .amdhsa_float_denorm_mode_32 3
.end_amdhsa_kernel
```
